```python
import torch

def _softmax(x, axis=-1):
    return torch.softmax(x, dim=axis)
def _gelu(x):
    return torch.nn.functional.gelu(x, approximate="tanh")
def _silu(x):
    return torch.nn.functional.silu(x)
def _sigmoid(x):
    return torch.sigmoid(x)
def _layernorm(x, axis=-1, eps=1e-5):
    m = x.mean(dim=axis, keepdim=True)
    v = x.var(dim=axis, keepdim=True, unbiased=False)
    return (x - m) / torch.sqrt(v + eps)
def _scatter_add(tgt, idx, src, axis=0):
    return tgt.clone().index_add_(axis, idx, src)
def _segment_sum(src, seg, n):
    out = torch.zeros((n,) + src.shape[1:], dtype=src.dtype)
    return out.index_add_(0, seg, src)
def _pad(x, pw):
    flat = tuple(v for pair in reversed(pw) for v in pair)
    return torch.nn.functional.pad(x, flat)

kernel_name = 'standalone__kernel_systems_refs_featgraph__graph'

def setup_inputs():

    _w = (lambda a: (lambda t: t.to(torch.bfloat16) if t.is_floating_point() else t)(torch.as_tensor(a)))
    N, deg, D = 50000, 16, 64
    E = N * deg
    scale = D ** -0.5
    src = (lambda lo, hi, *s: torch.randint(lo, hi, s))(0, N, E).to(torch.int64)
    dst = (lambda lo, hi, *s: torch.randint(lo, hi, s))(0, N, E).to(torch.int64)
    return {
        "x": _w((lambda *s: torch.randn(*s, dtype=torch.bfloat16) * 0.8)(N, D)),
        "src": _w(src),
        "dst": _w(dst),
        "w_q": _w((lambda *s: torch.randn(*s, dtype=torch.bfloat16) * 0.8)(D, D) * scale),
        "w_v": _w((lambda *s: torch.randn(*s, dtype=torch.bfloat16) * 0.05)(D, D) * scale),
    }

def reference(x, src, dst, w_q, w_v):
    N, D = x.shape
    xs = x[src]
    xd = x[dst]
    q = xd @ w_q
    logits = torch.einsum('ed,ed->e', xs, q) * (float(D) ** -0.5)
    alpha = _sigmoid(logits)
    msg = alpha[:, None] * (xs @ w_v)
    return _segment_sum(msg, dst, N)
```

```asm
; @launch kernel=fg_part_kernel grid=(251,1,1) block=(1024,1,1) lds=1088
; @launch kernel=standalone__kernel_systems_refs_featgraph__graph_kernel grid=(241,1,1) block=(832,1,1) lds=52480
.amdgcn_target "amdgcn-amd-amdhsa--gfx950"
.text
.globl fg_part_kernel
.p2align 8
.type fg_part_kernel,@function
fg_part_kernel:
  s_cmp_gt_u32 s2, 250
  s_cbranch_scc1 K1_END
  s_cmp_eq_u32 s2, 250
  s_cbranch_scc1 K1_FRAG
  s_load_dwordx2 s[4:5], s[0:1], 8
  s_load_dwordx2 s[6:7], s[0:1], 16
  s_load_dwordx2 s[8:9], s[0:1], 56
  v_lshlrev_b32 v1, 2, v0
  v_mov_b32 v2, 0
  v_cmp_gt_u32 vcc, 257, v0
  s_and_saveexec_b64 s[40:41], vcc
  ds_write_b32 v1, v2
  s_mov_b64 exec, s[40:41]
  s_waitcnt lgkmcnt(0)
  s_mov_b32 s12, s4
  s_mov_b32 s13, s5
  s_mov_b32 s14, 3200000
  s_mov_b32 s15, 0x00020000
  s_mov_b32 s16, s6
  s_mov_b32 s17, s7
  s_mov_b32 s18, 3200000
  s_mov_b32 s19, 0x00020000
  s_mov_b32 s24, s8
  s_mov_b32 s25, s9
  s_mov_b32 s26, 3200000
  s_mov_b32 s27, 0x00020000
  s_add_u32 s10, s8, 4194304
  s_addc_u32 s11, s9, 0
  s_mov_b32 s28, s10
  s_mov_b32 s29, s11
  s_mov_b32 s30, 244000
  s_mov_b32 s31, 0x00020000
  s_mul_i32 s3, s2, 12800
  v_lshlrev_b32 v3, 4, v0
  v_add_u32 v3, s3, v3
  v_cmp_gt_u32 vcc, 800, v0
  s_and_saveexec_b64 s[40:41], vcc
  buffer_load_dwordx4 v[4:7], v3, s[16:19], 0 offen
  buffer_load_dwordx4 v[8:11], v3, s[12:15], 0 offen
  s_mov_b64 exec, s[40:41]
  s_barrier
  s_waitcnt vmcnt(0)
  s_mov_b32 s20, 80660
  s_mov_b32 s21, 208
  v_mov_b32 v2, 1
  s_and_saveexec_b64 s[40:41], vcc
  v_mul_u32_u24 v12, s20, v4
  v_lshrrev_b32 v12, 24, v12
  v_mul_u32_u24 v20, s21, v12
  v_sub_u32 v20, v4, v20
  v_lshl_or_b32 v8, v8, 8, v20
  v_lshlrev_b32 v12, 2, v12
  ds_add_rtn_u32 v16, v12, v2
  v_mul_u32_u24 v13, s20, v5
  v_lshrrev_b32 v13, 24, v13
  v_mul_u32_u24 v20, s21, v13
  v_sub_u32 v20, v5, v20
  v_lshl_or_b32 v9, v9, 8, v20
  v_lshlrev_b32 v13, 2, v13
  ds_add_rtn_u32 v17, v13, v2
  v_mul_u32_u24 v14, s20, v6
  v_lshrrev_b32 v14, 24, v14
  v_mul_u32_u24 v20, s21, v14
  v_sub_u32 v20, v6, v20
  v_lshl_or_b32 v10, v10, 8, v20
  v_lshlrev_b32 v14, 2, v14
  ds_add_rtn_u32 v18, v14, v2
  v_mul_u32_u24 v15, s20, v7
  v_lshrrev_b32 v15, 24, v15
  v_mul_u32_u24 v20, s21, v15
  v_sub_u32 v20, v7, v20
  v_lshl_or_b32 v11, v11, 8, v20
  v_lshlrev_b32 v15, 2, v15
  ds_add_rtn_u32 v19, v15, v2
  s_mov_b64 exec, s[40:41]
  s_waitcnt lgkmcnt(0)
  s_barrier
  v_cmp_gt_u32 vcc, 64, v0
  s_and_saveexec_b64 s[42:43], vcc
  s_cbranch_execz K1_NOSCAN
  v_lshlrev_b32 v21, 4, v0
  ds_read_b128 v[24:27], v21
  s_waitcnt lgkmcnt(0)
  v_add_u32 v28, v24, v25
  v_add_u32 v29, v28, v26
  v_add_u32 v30, v29, v27
  v_mov_b32 v31, v30
  s_nop 1
  v_add_u32_dpp v31, v31, v31 row_shr:1 row_mask:0xf bank_mask:0xf bound_ctrl:0
  s_nop 1
  v_add_u32_dpp v31, v31, v31 row_shr:2 row_mask:0xf bank_mask:0xf bound_ctrl:0
  s_nop 1
  v_add_u32_dpp v31, v31, v31 row_shr:4 row_mask:0xf bank_mask:0xf bound_ctrl:0
  s_nop 1
  v_add_u32_dpp v31, v31, v31 row_shr:8 row_mask:0xf bank_mask:0xf bound_ctrl:0
  s_nop 1
  v_add_u32_dpp v31, v31, v31 row_bcast:15 row_mask:0xa bank_mask:0xf
  s_nop 1
  v_add_u32_dpp v31, v31, v31 row_bcast:31 row_mask:0xc bank_mask:0xf
  s_nop 1
  v_sub_u32 v32, v31, v30
  v_add_u32 v33, v32, v24
  v_add_u32 v34, v32, v28
  v_add_u32 v35, v32, v29
  ds_write_b128 v21, v[32:35]
  v_cmp_eq_u32 vcc, 63, v0
  s_and_b64 exec, exec, vcc
  v_mov_b32 v22, 1024
  ds_write_b32 v22, v31
K1_NOSCAN:
  s_mov_b64 exec, s[42:43]
  s_waitcnt lgkmcnt(0)
  s_barrier
  v_cmp_gt_u32 vcc, 800, v0
  s_and_saveexec_b64 s[40:41], vcc
  ds_read_b32 v24, v12
  ds_read_b32 v25, v13
  ds_read_b32 v26, v14
  ds_read_b32 v27, v15
  s_waitcnt lgkmcnt(0)
  v_add_u32 v24, v24, v16
  v_lshlrev_b32 v24, 2, v24
  v_add_u32 v24, s3, v24
  buffer_store_dword v8, v24, s[24:27], 0 offen
  v_add_u32 v25, v25, v17
  v_lshlrev_b32 v25, 2, v25
  v_add_u32 v25, s3, v25
  buffer_store_dword v9, v25, s[24:27], 0 offen
  v_add_u32 v26, v26, v18
  v_lshlrev_b32 v26, 2, v26
  v_add_u32 v26, s3, v26
  buffer_store_dword v10, v26, s[24:27], 0 offen
  v_add_u32 v27, v27, v19
  v_lshlrev_b32 v27, 2, v27
  v_add_u32 v27, s3, v27
  buffer_store_dword v11, v27, s[24:27], 0 offen
  s_mov_b64 exec, s[40:41]
  v_cmp_gt_u32 vcc, 242, v0
  s_and_saveexec_b64 s[40:41], vcc
  ds_read_b32 v30, v1
  s_mul_i32 s22, s2, 976
  v_add_u32 v31, s22, v1
  s_waitcnt lgkmcnt(0)
  buffer_store_dword v30, v31, s[28:31], 0 offen
  s_mov_b64 exec, s[40:41]
  s_branch K1_END
K1_FRAG:
  s_load_dwordx2 s[4:5], s[0:1], 24
  s_load_dwordx2 s[6:7], s[0:1], 32
  s_load_dwordx2 s[8:9], s[0:1], 56
  v_and_b32 v1, 63, v0
  v_and_b32 v3, 15, v1
  v_lshrrev_b32 v4, 4, v1
  v_bfe_u32 v5, v0, 6, 3
  s_waitcnt lgkmcnt(0)
  s_mov_b32 s12, s4
  s_mov_b32 s13, s5
  s_mov_b32 s14, 8192
  s_mov_b32 s15, 0x00020000
  s_mov_b32 s16, s6
  s_mov_b32 s17, s7
  s_mov_b32 s18, 8192
  s_mov_b32 s19, 0x00020000
  s_add_u32 s10, s8, 4718592
  s_addc_u32 s11, s9, 0
  s_mov_b32 s24, s10
  s_mov_b32 s25, s11
  s_mov_b32 s26, 16384
  s_mov_b32 s27, 0x00020000
  v_lshlrev_b32 v30, 4, v0
  v_cmp_gt_u32 vcc, 512, v0
  s_and_saveexec_b64 s[40:41], vcc
  s_cbranch_execz K1_FV
  v_and_b32 v6, 1, v5
  v_lshrrev_b32 v7, 1, v5
  v_lshlrev_b32 v8, 12, v6
  v_lshl_add_u32 v8, v4, 10, v8
  v_lshl_add_u32 v8, v7, 5, v8
  v_lshl_add_u32 v8, v3, 1, v8
  buffer_load_ushort v10, v8, s[12:15], 0 offen offset:0
  buffer_load_ushort v11, v8, s[12:15], 0 offen offset:128
  buffer_load_ushort v12, v8, s[12:15], 0 offen offset:256
  buffer_load_ushort v13, v8, s[12:15], 0 offen offset:384
  buffer_load_ushort v14, v8, s[12:15], 0 offen offset:512
  buffer_load_ushort v15, v8, s[12:15], 0 offen offset:640
  buffer_load_ushort v16, v8, s[12:15], 0 offen offset:768
  buffer_load_ushort v17, v8, s[12:15], 0 offen offset:896
  s_waitcnt vmcnt(0)
  v_lshl_or_b32 v20, v11, 16, v10
  v_lshl_or_b32 v21, v13, 16, v12
  v_lshl_or_b32 v22, v15, 16, v14
  v_lshl_or_b32 v23, v17, 16, v16
  buffer_store_dwordx4 v[20:23], v30, s[24:27], 0 offen
K1_FV:
  s_andn2_b64 exec, s[40:41], exec
  s_cbranch_execz K1_END
  v_lshrrev_b32 v6, 2, v5
  v_and_b32 v7, 3, v5
  v_lshlrev_b32 v8, 12, v6
  v_lshl_add_u32 v8, v4, 9, v8
  v_lshl_add_u32 v8, v7, 5, v8
  v_lshl_add_u32 v8, v3, 1, v8
  buffer_load_ushort v10, v8, s[16:19], 0 offen offset:0
  buffer_load_ushort v11, v8, s[16:19], 0 offen offset:128
  buffer_load_ushort v12, v8, s[16:19], 0 offen offset:256
  buffer_load_ushort v13, v8, s[16:19], 0 offen offset:384
  buffer_load_ushort v14, v8, s[16:19], 0 offen offset:2048
  buffer_load_ushort v15, v8, s[16:19], 0 offen offset:2176
  buffer_load_ushort v16, v8, s[16:19], 0 offen offset:2304
  buffer_load_ushort v17, v8, s[16:19], 0 offen offset:2432
  s_waitcnt vmcnt(0)
  v_lshl_or_b32 v20, v11, 16, v10
  v_lshl_or_b32 v21, v13, 16, v12
  v_lshl_or_b32 v22, v15, 16, v14
  v_lshl_or_b32 v23, v17, 16, v16
  buffer_store_dwordx4 v[20:23], v30, s[24:27], 0 offen
K1_END:
  s_endpgm
.globl standalone__kernel_systems_refs_featgraph__graph_kernel
.p2align 8
.type standalone__kernel_systems_refs_featgraph__graph_kernel,@function
standalone__kernel_systems_refs_featgraph__graph_kernel:
  s_cmp_ge_u32 s2, 241
  s_cbranch_scc1 K2_END
  s_load_dwordx2 s[4:5], s[0:1], 0
  s_load_dwordx2 s[10:11], s[0:1], 40
  s_load_dwordx2 s[12:13], s[0:1], 56
  v_lshrrev_b32 v1, 6, v0
  s_nop 0
  v_readfirstlane_b32 s44, v1
  v_and_b32 v1, 63, v0
  s_waitcnt lgkmcnt(0)
  s_mov_b32 s16, s4
  s_mov_b32 s17, s5
  s_mov_b32 s18, 6400000
  s_mov_b32 s19, 0x00020000
  s_mov_b32 s28, s10
  s_mov_b32 s29, s11
  s_mov_b32 s30, 6400000
  s_mov_b32 s31, 0x00020000
  s_mov_b32 s32, s12
  s_mov_b32 s33, s13
  s_mov_b32 s34, 3200000
  s_mov_b32 s35, 0x00020000
  s_add_u32 s14, s12, 4194304
  s_addc_u32 s15, s13, 0
  s_mov_b32 s36, s14
  s_mov_b32 s37, s15
  s_mov_b32 s38, 244000
  s_mov_b32 s39, 0x00020000
  s_add_u32 s14, s12, 4718592
  s_addc_u32 s15, s13, 0
  s_mov_b32 s20, s14
  s_mov_b32 s21, s15
  s_mov_b32 s22, 16384
  s_mov_b32 s23, 0x00020000
  s_mul_i32 s40, s2, 208
  s_sub_u32 s41, 50000, s40
  s_min_u32 s41, s41, 208
  v_mov_b32 v2, 976
  v_mul_u32_u24 v2, v2, v0
  s_lshl_b32 s3, s2, 2
  v_add_u32 v2, s3, v2
  v_mov_b32 v10, 0
  v_mov_b32 v11, 0
  v_cmp_gt_u32 vcc, 250, v0
  s_and_saveexec_b64 s[46:47], vcc
  buffer_load_dwordx2 v[10:11], v2, s[36:39], 0 offen
  s_mov_b64 exec, s[46:47]
  v_and_b32 v3, 15, v1
  v_lshrrev_b32 v4, 4, v1
  v_lshlrev_b32 v7, 4, v4
  s_mul_i32 s45, s44, 2304
  s_add_u32 s45, s45, 22528
  v_mul_u32_u24 v5, 144, v3
  v_add_u32 v5, v5, v7
  v_add_u32 v5, s45, v5
  v_lshrrev_b32 v6, 2, v3
  v_lshl_add_u32 v6, v4, 2, v6
  v_mul_u32_u24 v6, 144, v6
  v_and_b32 v8, 3, v3
  v_lshl_add_u32 v6, v8, 3, v6
  v_add_u32 v6, s45, v6
  v_lshlrev_b32 v8, 4, v1
  buffer_load_dwordx4 v[64:67], v8, s[20:23], 0 offen offset:0
  buffer_load_dwordx4 v[68:71], v8, s[20:23], 0 offen offset:1024
  buffer_load_dwordx4 v[72:75], v8, s[20:23], 0 offen offset:2048
  buffer_load_dwordx4 v[76:79], v8, s[20:23], 0 offen offset:3072
  v_add_u32 v9, 4096, v8
  buffer_load_dwordx4 v[80:83], v9, s[20:23], 0 offen offset:0
  buffer_load_dwordx4 v[84:87], v9, s[20:23], 0 offen offset:1024
  buffer_load_dwordx4 v[88:91], v9, s[20:23], 0 offen offset:2048
  buffer_load_dwordx4 v[92:95], v9, s[20:23], 0 offen offset:3072
  s_lshl_b32 s3, s44, 4
  s_add_u32 s3, s3, s40
  v_add_u32 v24, s3, v3
  v_lshlrev_b32 v24, 7, v24
  v_add_u32 v24, v24, v7
  buffer_load_dwordx4 v[112:115], v24, s[16:19], 0 offen
  buffer_load_dwordx4 v[116:119], v24, s[16:19], 0 offen offset:64
  s_waitcnt vmcnt(0)
  v_mfma_f32_16x16x32_bf16 v[96:99], v[64:67], v[112:115], 0
  v_mfma_f32_16x16x32_bf16 v[96:99], v[68:71], v[116:119], v[96:99]
  v_mfma_f32_16x16x32_bf16 v[100:103], v[72:75], v[112:115], 0
  v_mfma_f32_16x16x32_bf16 v[100:103], v[76:79], v[116:119], v[100:103]
  v_mfma_f32_16x16x32_bf16 v[104:107], v[80:83], v[112:115], 0
  v_mfma_f32_16x16x32_bf16 v[104:107], v[84:87], v[116:119], v[104:107]
  v_mfma_f32_16x16x32_bf16 v[108:111], v[88:91], v[112:115], 0
  v_mfma_f32_16x16x32_bf16 v[108:111], v[92:95], v[116:119], v[108:111]
  s_nop 7
  s_nop 7
  v_mul_u32_u24 v24, 144, v3
  v_lshl_add_u32 v24, v4, 3, v24
  v_add_u32 v24, s45, v24
  v_cvt_pk_bf16_f32 v26, v96, v97
  v_cvt_pk_bf16_f32 v27, v98, v99
  ds_write_b64 v24, v[26:27] offset:0
  v_cvt_pk_bf16_f32 v26, v100, v101
  v_cvt_pk_bf16_f32 v27, v102, v103
  ds_write_b64 v24, v[26:27] offset:32
  v_cvt_pk_bf16_f32 v26, v104, v105
  v_cvt_pk_bf16_f32 v27, v106, v107
  ds_write_b64 v24, v[26:27] offset:64
  v_cvt_pk_bf16_f32 v26, v108, v109
  v_cvt_pk_bf16_f32 v27, v110, v111
  ds_write_b64 v24, v[26:27] offset:96
  s_waitcnt lgkmcnt(0)
  ds_read_b128 v[16:19], v5
  ds_read_b128 v[20:23], v5 offset:64
  v_mov_b32 v96, 0
  v_mov_b32 v97, 0
  v_mov_b32 v98, 0
  v_mov_b32 v99, 0
  v_mov_b32 v100, 0
  v_mov_b32 v101, 0
  v_mov_b32 v102, 0
  v_mov_b32 v103, 0
  v_mov_b32 v104, 0
  v_mov_b32 v105, 0
  v_mov_b32 v106, 0
  v_mov_b32 v107, 0
  v_mov_b32 v108, 0
  v_mov_b32 v109, 0
  v_mov_b32 v110, 0
  v_mov_b32 v111, 0
  v_sub_u32 v12, v11, v10
  v_mov_b32 v28, v12
  s_nop 1
  v_add_u32_dpp v28, v28, v28 row_shr:1 row_mask:0xf bank_mask:0xf bound_ctrl:0
  s_nop 1
  v_add_u32_dpp v28, v28, v28 row_shr:2 row_mask:0xf bank_mask:0xf bound_ctrl:0
  s_nop 1
  v_add_u32_dpp v28, v28, v28 row_shr:4 row_mask:0xf bank_mask:0xf bound_ctrl:0
  s_nop 1
  v_add_u32_dpp v28, v28, v28 row_shr:8 row_mask:0xf bank_mask:0xf bound_ctrl:0
  s_nop 1
  v_add_u32_dpp v28, v28, v28 row_bcast:15 row_mask:0xa bank_mask:0xf
  s_nop 1
  v_add_u32_dpp v28, v28, v28 row_bcast:31 row_mask:0xc bank_mask:0xf
  s_nop 1
  v_cmp_eq_u32 vcc, 63, v1
  s_and_saveexec_b64 s[46:47], vcc
  s_lshl_b32 s3, s44, 2
  v_mov_b32 v29, 2368
  v_add_u32 v29, s3, v29
  ds_write_b32 v29, v28
  s_mov_b64 exec, s[46:47]
  s_waitcnt lgkmcnt(0)
  s_barrier
  v_mov_b32 v29, 2368
  ds_read_b128 v[30:33], v29
  s_waitcnt lgkmcnt(0)
  v_readfirstlane_b32 s48, v30
  v_readfirstlane_b32 s49, v31
  v_readfirstlane_b32 s50, v32
  v_readfirstlane_b32 s51, v33
  s_add_u32 s49, s49, s48
  s_add_u32 s50, s50, s49
  s_add_u32 s42, s51, s50
  s_mov_b32 s3, 0
  s_cmp_eq_u32 s44, 1
  s_cselect_b32 s3, s48, s3
  s_cmp_eq_u32 s44, 2
  s_cselect_b32 s3, s49, s3
  s_cmp_eq_u32 s44, 3
  s_cselect_b32 s3, s50, s3
  v_sub_u32 v12, v28, v12
  v_add_u32 v12, s3, v12
  v_cmp_gt_u32 vcc, 256, v0
  s_and_saveexec_b64 s[46:47], vcc
  v_lshlrev_b32 v14, 2, v0
  v_mul_u32_u24 v15, 3200, v0
  v_add_u32 v15, v15, v10
  v_sub_u32 v15, v15, v12
  ds_write_b32 v14, v12 offset:0
  ds_write_b32 v14, v15 offset:1088
  s_mov_b64 exec, s[46:47]
  s_mov_b32 s43, 0
K2_ROUND:
  v_mov_b32 v24, -1
  v_mov_b32 v25, -1
  v_mov_b32 v26, -1
  v_mov_b32 v27, -1
  v_lshlrev_b32 v28, 4, v0
  ds_write_b128 v28, v[24:27] offset:4096
  v_cmp_gt_u32 vcc, 320, v0
  s_and_saveexec_b64 s[46:47], vcc
  ds_write_b128 v28, v[24:27] offset:17408
  s_mov_b64 exec, s[46:47]
  v_cmp_gt_u32 vcc, 16, v0
  s_and_saveexec_b64 s[46:47], vcc
  v_lshlrev_b32 v28, 2, v0
  v_mov_b32 v24, 0
  ds_write_b32 v28, v24 offset:2112
  s_mov_b64 exec, s[46:47]
  s_waitcnt lgkmcnt(0)
  s_barrier
  s_add_u32 s71, s43, 4096
  s_min_u32 s71, s71, s42
  v_add_u32 v36, s43, v0
  v_mov_b32 v41, 0
  v_add_u32 v37, s43, v0
  v_add_u32 v37, 832, v37
  v_mov_b32 v42, 0
  v_add_u32 v38, s43, v0
  v_add_u32 v38, 1664, v38
  v_mov_b32 v43, 0
  v_add_u32 v39, s43, v0
  v_add_u32 v39, 2496, v39
  v_mov_b32 v44, 0
  v_add_u32 v40, s43, v0
  v_add_u32 v40, 3328, v40
  v_mov_b32 v45, 0
  v_add_u32 v46, 128, v41
  v_lshlrev_b32 v51, 2, v46
  ds_read_b32 v51, v51 offset:0
  v_add_u32 v47, 128, v42
  v_lshlrev_b32 v52, 2, v47
  ds_read_b32 v52, v52 offset:0
  v_add_u32 v48, 128, v43
  v_lshlrev_b32 v53, 2, v48
  ds_read_b32 v53, v53 offset:0
  v_add_u32 v49, 128, v44
  v_lshlrev_b32 v54, 2, v49
  ds_read_b32 v54, v54 offset:0
  v_add_u32 v50, 128, v45
  v_lshlrev_b32 v55, 2, v50
  ds_read_b32 v55, v55 offset:0
  s_waitcnt lgkmcnt(0)
  v_cmp_le_u32 vcc, v51, v36
  s_nop 1
  v_cndmask_b32 v41, v41, v46, vcc
  v_cmp_le_u32 vcc, v52, v37
  s_nop 1
  v_cndmask_b32 v42, v42, v47, vcc
  v_cmp_le_u32 vcc, v53, v38
  s_nop 1
  v_cndmask_b32 v43, v43, v48, vcc
  v_cmp_le_u32 vcc, v54, v39
  s_nop 1
  v_cndmask_b32 v44, v44, v49, vcc
  v_cmp_le_u32 vcc, v55, v40
  s_nop 1
  v_cndmask_b32 v45, v45, v50, vcc
  v_add_u32 v46, 64, v41
  v_lshlrev_b32 v51, 2, v46
  ds_read_b32 v51, v51 offset:0
  v_add_u32 v47, 64, v42
  v_lshlrev_b32 v52, 2, v47
  ds_read_b32 v52, v52 offset:0
  v_add_u32 v48, 64, v43
  v_lshlrev_b32 v53, 2, v48
  ds_read_b32 v53, v53 offset:0
  v_add_u32 v49, 64, v44
  v_lshlrev_b32 v54, 2, v49
  ds_read_b32 v54, v54 offset:0
  v_add_u32 v50, 64, v45
  v_lshlrev_b32 v55, 2, v50
  ds_read_b32 v55, v55 offset:0
  s_waitcnt lgkmcnt(0)
  v_cmp_le_u32 vcc, v51, v36
  s_nop 1
  v_cndmask_b32 v41, v41, v46, vcc
  v_cmp_le_u32 vcc, v52, v37
  s_nop 1
  v_cndmask_b32 v42, v42, v47, vcc
  v_cmp_le_u32 vcc, v53, v38
  s_nop 1
  v_cndmask_b32 v43, v43, v48, vcc
  v_cmp_le_u32 vcc, v54, v39
  s_nop 1
  v_cndmask_b32 v44, v44, v49, vcc
  v_cmp_le_u32 vcc, v55, v40
  s_nop 1
  v_cndmask_b32 v45, v45, v50, vcc
  v_add_u32 v46, 32, v41
  v_lshlrev_b32 v51, 2, v46
  ds_read_b32 v51, v51 offset:0
  v_add_u32 v47, 32, v42
  v_lshlrev_b32 v52, 2, v47
  ds_read_b32 v52, v52 offset:0
  v_add_u32 v48, 32, v43
  v_lshlrev_b32 v53, 2, v48
  ds_read_b32 v53, v53 offset:0
  v_add_u32 v49, 32, v44
  v_lshlrev_b32 v54, 2, v49
  ds_read_b32 v54, v54 offset:0
  v_add_u32 v50, 32, v45
  v_lshlrev_b32 v55, 2, v50
  ds_read_b32 v55, v55 offset:0
  s_waitcnt lgkmcnt(0)
  v_cmp_le_u32 vcc, v51, v36
  s_nop 1
  v_cndmask_b32 v41, v41, v46, vcc
  v_cmp_le_u32 vcc, v52, v37
  s_nop 1
  v_cndmask_b32 v42, v42, v47, vcc
  v_cmp_le_u32 vcc, v53, v38
  s_nop 1
  v_cndmask_b32 v43, v43, v48, vcc
  v_cmp_le_u32 vcc, v54, v39
  s_nop 1
  v_cndmask_b32 v44, v44, v49, vcc
  v_cmp_le_u32 vcc, v55, v40
  s_nop 1
  v_cndmask_b32 v45, v45, v50, vcc
  v_add_u32 v46, 16, v41
  v_lshlrev_b32 v51, 2, v46
  ds_read_b32 v51, v51 offset:0
  v_add_u32 v47, 16, v42
  v_lshlrev_b32 v52, 2, v47
  ds_read_b32 v52, v52 offset:0
  v_add_u32 v48, 16, v43
  v_lshlrev_b32 v53, 2, v48
  ds_read_b32 v53, v53 offset:0
  v_add_u32 v49, 16, v44
  v_lshlrev_b32 v54, 2, v49
  ds_read_b32 v54, v54 offset:0
  v_add_u32 v50, 16, v45
  v_lshlrev_b32 v55, 2, v50
  ds_read_b32 v55, v55 offset:0
  s_waitcnt lgkmcnt(0)
  v_cmp_le_u32 vcc, v51, v36
  s_nop 1
  v_cndmask_b32 v41, v41, v46, vcc
  v_cmp_le_u32 vcc, v52, v37
  s_nop 1
  v_cndmask_b32 v42, v42, v47, vcc
  v_cmp_le_u32 vcc, v53, v38
  s_nop 1
  v_cndmask_b32 v43, v43, v48, vcc
  v_cmp_le_u32 vcc, v54, v39
  s_nop 1
  v_cndmask_b32 v44, v44, v49, vcc
  v_cmp_le_u32 vcc, v55, v40
  s_nop 1
  v_cndmask_b32 v45, v45, v50, vcc
  v_add_u32 v46, 8, v41
  v_lshlrev_b32 v51, 2, v46
  ds_read_b32 v51, v51 offset:0
  v_add_u32 v47, 8, v42
  v_lshlrev_b32 v52, 2, v47
  ds_read_b32 v52, v52 offset:0
  v_add_u32 v48, 8, v43
  v_lshlrev_b32 v53, 2, v48
  ds_read_b32 v53, v53 offset:0
  v_add_u32 v49, 8, v44
  v_lshlrev_b32 v54, 2, v49
  ds_read_b32 v54, v54 offset:0
  v_add_u32 v50, 8, v45
  v_lshlrev_b32 v55, 2, v50
  ds_read_b32 v55, v55 offset:0
  s_waitcnt lgkmcnt(0)
  v_cmp_le_u32 vcc, v51, v36
  s_nop 1
  v_cndmask_b32 v41, v41, v46, vcc
  v_cmp_le_u32 vcc, v52, v37
  s_nop 1
  v_cndmask_b32 v42, v42, v47, vcc
  v_cmp_le_u32 vcc, v53, v38
  s_nop 1
  v_cndmask_b32 v43, v43, v48, vcc
  v_cmp_le_u32 vcc, v54, v39
  s_nop 1
  v_cndmask_b32 v44, v44, v49, vcc
  v_cmp_le_u32 vcc, v55, v40
  s_nop 1
  v_cndmask_b32 v45, v45, v50, vcc
  v_add_u32 v46, 4, v41
  v_lshlrev_b32 v51, 2, v46
  ds_read_b32 v51, v51 offset:0
  v_add_u32 v47, 4, v42
  v_lshlrev_b32 v52, 2, v47
  ds_read_b32 v52, v52 offset:0
  v_add_u32 v48, 4, v43
  v_lshlrev_b32 v53, 2, v48
  ds_read_b32 v53, v53 offset:0
  v_add_u32 v49, 4, v44
  v_lshlrev_b32 v54, 2, v49
  ds_read_b32 v54, v54 offset:0
  v_add_u32 v50, 4, v45
  v_lshlrev_b32 v55, 2, v50
  ds_read_b32 v55, v55 offset:0
  s_waitcnt lgkmcnt(0)
  v_cmp_le_u32 vcc, v51, v36
  s_nop 1
  v_cndmask_b32 v41, v41, v46, vcc
  v_cmp_le_u32 vcc, v52, v37
  s_nop 1
  v_cndmask_b32 v42, v42, v47, vcc
  v_cmp_le_u32 vcc, v53, v38
  s_nop 1
  v_cndmask_b32 v43, v43, v48, vcc
  v_cmp_le_u32 vcc, v54, v39
  s_nop 1
  v_cndmask_b32 v44, v44, v49, vcc
  v_cmp_le_u32 vcc, v55, v40
  s_nop 1
  v_cndmask_b32 v45, v45, v50, vcc
  v_add_u32 v46, 2, v41
  v_lshlrev_b32 v51, 2, v46
  ds_read_b32 v51, v51 offset:0
  v_add_u32 v47, 2, v42
  v_lshlrev_b32 v52, 2, v47
  ds_read_b32 v52, v52 offset:0
  v_add_u32 v48, 2, v43
  v_lshlrev_b32 v53, 2, v48
  ds_read_b32 v53, v53 offset:0
  v_add_u32 v49, 2, v44
  v_lshlrev_b32 v54, 2, v49
  ds_read_b32 v54, v54 offset:0
  v_add_u32 v50, 2, v45
  v_lshlrev_b32 v55, 2, v50
  ds_read_b32 v55, v55 offset:0
  s_waitcnt lgkmcnt(0)
  v_cmp_le_u32 vcc, v51, v36
  s_nop 1
  v_cndmask_b32 v41, v41, v46, vcc
  v_cmp_le_u32 vcc, v52, v37
  s_nop 1
  v_cndmask_b32 v42, v42, v47, vcc
  v_cmp_le_u32 vcc, v53, v38
  s_nop 1
  v_cndmask_b32 v43, v43, v48, vcc
  v_cmp_le_u32 vcc, v54, v39
  s_nop 1
  v_cndmask_b32 v44, v44, v49, vcc
  v_cmp_le_u32 vcc, v55, v40
  s_nop 1
  v_cndmask_b32 v45, v45, v50, vcc
  v_add_u32 v46, 1, v41
  v_lshlrev_b32 v51, 2, v46
  ds_read_b32 v51, v51 offset:0
  v_add_u32 v47, 1, v42
  v_lshlrev_b32 v52, 2, v47
  ds_read_b32 v52, v52 offset:0
  v_add_u32 v48, 1, v43
  v_lshlrev_b32 v53, 2, v48
  ds_read_b32 v53, v53 offset:0
  v_add_u32 v49, 1, v44
  v_lshlrev_b32 v54, 2, v49
  ds_read_b32 v54, v54 offset:0
  v_add_u32 v50, 1, v45
  v_lshlrev_b32 v55, 2, v50
  ds_read_b32 v55, v55 offset:0
  s_waitcnt lgkmcnt(0)
  v_cmp_le_u32 vcc, v51, v36
  s_nop 1
  v_cndmask_b32 v41, v41, v46, vcc
  v_cmp_le_u32 vcc, v52, v37
  s_nop 1
  v_cndmask_b32 v42, v42, v47, vcc
  v_cmp_le_u32 vcc, v53, v38
  s_nop 1
  v_cndmask_b32 v43, v43, v48, vcc
  v_cmp_le_u32 vcc, v54, v39
  s_nop 1
  v_cndmask_b32 v44, v44, v49, vcc
  v_cmp_le_u32 vcc, v55, v40
  s_nop 1
  v_cndmask_b32 v45, v45, v50, vcc
  v_lshlrev_b32 v51, 2, v41
  ds_read_b32 v51, v51 offset:1088
  v_lshlrev_b32 v52, 2, v42
  ds_read_b32 v52, v52 offset:1088
  v_lshlrev_b32 v53, 2, v43
  ds_read_b32 v53, v53 offset:1088
  v_lshlrev_b32 v54, 2, v44
  ds_read_b32 v54, v54 offset:1088
  v_lshlrev_b32 v55, 2, v45
  ds_read_b32 v55, v55 offset:1088
  s_waitcnt lgkmcnt(0)
  v_mov_b32 v24, 1
  s_mov_b64 s[46:47], exec
  v_add_u32 v51, v51, v36
  v_lshlrev_b32 v51, 2, v51
  v_cmp_gt_u32 s[52:53], s71, v36
  s_mov_b64 exec, s[52:53]
  buffer_load_dword v41, v51, s[32:35], 0 offen
  s_mov_b64 exec, s[46:47]
  v_add_u32 v52, v52, v37
  v_lshlrev_b32 v52, 2, v52
  v_cmp_gt_u32 s[54:55], s71, v37
  s_mov_b64 exec, s[54:55]
  buffer_load_dword v42, v52, s[32:35], 0 offen
  s_mov_b64 exec, s[46:47]
  v_add_u32 v53, v53, v38
  v_lshlrev_b32 v53, 2, v53
  v_cmp_gt_u32 s[56:57], s71, v38
  s_mov_b64 exec, s[56:57]
  buffer_load_dword v43, v53, s[32:35], 0 offen
  s_mov_b64 exec, s[46:47]
  v_add_u32 v54, v54, v39
  v_lshlrev_b32 v54, 2, v54
  v_cmp_gt_u32 s[58:59], s71, v39
  s_mov_b64 exec, s[58:59]
  buffer_load_dword v44, v54, s[32:35], 0 offen
  s_mov_b64 exec, s[46:47]
  v_add_u32 v55, v55, v40
  v_lshlrev_b32 v55, 2, v55
  v_cmp_gt_u32 s[60:61], s71, v40
  s_mov_b64 exec, s[60:61]
  buffer_load_dword v45, v55, s[32:35], 0 offen
  s_mov_b64 exec, s[46:47]
  s_waitcnt vmcnt(0)
  s_mov_b64 exec, s[52:53]
  v_bfe_u32 v46, v41, 4, 4
  v_lshlrev_b32 v46, 2, v46
  ds_add_rtn_u32 v51, v46, v24 offset:2112
  s_mov_b64 exec, s[54:55]
  v_bfe_u32 v47, v42, 4, 4
  v_lshlrev_b32 v47, 2, v47
  ds_add_rtn_u32 v52, v47, v24 offset:2112
  s_mov_b64 exec, s[56:57]
  v_bfe_u32 v48, v43, 4, 4
  v_lshlrev_b32 v48, 2, v48
  ds_add_rtn_u32 v53, v48, v24 offset:2112
  s_mov_b64 exec, s[58:59]
  v_bfe_u32 v49, v44, 4, 4
  v_lshlrev_b32 v49, 2, v49
  ds_add_rtn_u32 v54, v49, v24 offset:2112
  s_mov_b64 exec, s[60:61]
  v_bfe_u32 v50, v45, 4, 4
  v_lshlrev_b32 v50, 2, v50
  ds_add_rtn_u32 v55, v50, v24 offset:2112
  s_mov_b64 exec, s[46:47]
  s_waitcnt lgkmcnt(0)
  s_barrier
  v_mov_b32 v12, 0
  v_lshlrev_b32 v28, 2, v1
  v_cmp_gt_u32 vcc, 16, v1
  s_and_saveexec_b64 s[46:47], vcc
  ds_read_b32 v12, v28 offset:2112
  s_waitcnt lgkmcnt(0)
  v_add_u32 v12, 15, v12
  v_and_b32 v12, -16, v12
  s_mov_b64 exec, s[46:47]
  v_mov_b32 v13, v12
  s_nop 1
  v_add_u32_dpp v13, v13, v13 row_shr:1 row_mask:0xf bank_mask:0xf bound_ctrl:0
  s_nop 1
  v_add_u32_dpp v13, v13, v13 row_shr:2 row_mask:0xf bank_mask:0xf bound_ctrl:0
  s_nop 1
  v_add_u32_dpp v13, v13, v13 row_shr:4 row_mask:0xf bank_mask:0xf bound_ctrl:0
  s_nop 1
  v_add_u32_dpp v13, v13, v13 row_shr:8 row_mask:0xf bank_mask:0xf bound_ctrl:0
  s_nop 1
  v_add_u32_dpp v13, v13, v13 row_bcast:15 row_mask:0xa bank_mask:0xf
  s_nop 1
  v_add_u32_dpp v13, v13, v13 row_bcast:31 row_mask:0xc bank_mask:0xf
  s_nop 1
  v_sub_u32 v12, v13, v12
  v_lshrrev_b32 v14, 4, v12
  v_lshrrev_b32 v15, 4, v13
  s_nop 1
  v_readlane_b32 s64, v14, s44
  v_readlane_b32 s65, v15, s44
  s_cmp_lg_u32 s44, 0
  s_cbranch_scc1 K2_NOPB
  v_cmp_gt_u32 vcc, 16, v1
  s_and_saveexec_b64 s[46:47], vcc
  ds_write_b32 v28, v12 offset:2240
  s_mov_b64 exec, s[46:47]
K2_NOPB:
  s_waitcnt lgkmcnt(0)
  s_barrier
  s_mov_b64 exec, s[52:53]
  ds_read_b32 v46, v46 offset:2240
  s_mov_b64 exec, s[54:55]
  ds_read_b32 v47, v47 offset:2240
  s_mov_b64 exec, s[56:57]
  ds_read_b32 v48, v48 offset:2240
  s_mov_b64 exec, s[58:59]
  ds_read_b32 v49, v49 offset:2240
  s_mov_b64 exec, s[60:61]
  ds_read_b32 v50, v50 offset:2240
  s_waitcnt lgkmcnt(0)
  s_mov_b64 exec, s[52:53]
  v_add_u32 v46, v46, v51
  v_lshlrev_b32 v46, 2, v46
  v_and_b32 v41, 0xffffff0f, v41
  ds_write_b32 v46, v41 offset:4096
  s_mov_b64 exec, s[54:55]
  v_add_u32 v47, v47, v52
  v_lshlrev_b32 v47, 2, v47
  v_and_b32 v42, 0xffffff0f, v42
  ds_write_b32 v47, v42 offset:4096
  s_mov_b64 exec, s[56:57]
  v_add_u32 v48, v48, v53
  v_lshlrev_b32 v48, 2, v48
  v_and_b32 v43, 0xffffff0f, v43
  ds_write_b32 v48, v43 offset:4096
  s_mov_b64 exec, s[58:59]
  v_add_u32 v49, v49, v54
  v_lshlrev_b32 v49, 2, v49
  v_and_b32 v44, 0xffffff0f, v44
  ds_write_b32 v49, v44 offset:4096
  s_mov_b64 exec, s[60:61]
  v_add_u32 v50, v50, v55
  v_lshlrev_b32 v50, 2, v50
  v_and_b32 v45, 0xffffff0f, v45
  ds_write_b32 v50, v45 offset:4096
  s_mov_b64 exec, s[46:47]
  s_waitcnt lgkmcnt(0)
  s_barrier
  s_cmp_ge_u32 s64, s65
  s_cbranch_scc1 K2_P2DONE
  s_lshl_b32 s3, s64, 6
  v_lshrrev_b32 v33, 3, v1
  v_mul_u32_u24 v57, 144, v33
  v_lshlrev_b32 v33, 2, v33
  v_add_u32 v33, s3, v33
  v_add_u32 v34, s3, v7
  v_and_b32 v56, 7, v1
  v_lshlrev_b32 v56, 4, v56
  v_add_u32 v57, v57, v56
  v_add_u32 v57, s45, v57
  ds_read_b32 v36, v33 offset:4096
  ds_read_b32 v37, v33 offset:4128
  ds_read_b32 v38, v33 offset:4160
  ds_read_b32 v39, v33 offset:4192
  ds_read_b32 v40, v33 offset:4224
  ds_read_b32 v41, v33 offset:4256
  ds_read_b32 v42, v33 offset:4288
  ds_read_b32 v43, v33 offset:4320
  ds_read_b32 v44, v33 offset:4352
  ds_read_b32 v45, v33 offset:4384
  ds_read_b128 v[58:61], v34 offset:4096
  s_waitcnt lgkmcnt(0)
  v_lshrrev_b32 v35, 8, v36
  v_lshl_add_u32 v35, v35, 7, v56
  buffer_load_dwordx4 v[64:67], v35, s[16:19], 0 offen
  v_lshrrev_b32 v35, 8, v37
  v_lshl_add_u32 v35, v35, 7, v56
  buffer_load_dwordx4 v[68:71], v35, s[16:19], 0 offen
  v_lshrrev_b32 v35, 8, v38
  v_lshl_add_u32 v35, v35, 7, v56
  buffer_load_dwordx4 v[72:75], v35, s[16:19], 0 offen
  v_lshrrev_b32 v35, 8, v39
  v_lshl_add_u32 v35, v35, 7, v56
  buffer_load_dwordx4 v[76:79], v35, s[16:19], 0 offen
  v_lshrrev_b32 v35, 8, v40
  v_lshl_add_u32 v35, v35, 7, v56
  buffer_load_dwordx4 v[80:83], v35, s[16:19], 0 offen
  v_lshrrev_b32 v35, 8, v41
  v_lshl_add_u32 v35, v35, 7, v56
  buffer_load_dwordx4 v[84:87], v35, s[16:19], 0 offen
  v_lshrrev_b32 v35, 8, v42
  v_lshl_add_u32 v35, v35, 7, v56
  buffer_load_dwordx4 v[88:91], v35, s[16:19], 0 offen
  v_lshrrev_b32 v35, 8, v43
  v_lshl_add_u32 v35, v35, 7, v56
  buffer_load_dwordx4 v[92:95], v35, s[16:19], 0 offen
  v_mov_b32 v36, v44
  v_mov_b32 v37, v45
  s_mov_b32 s70, 0xbe38aa3b
K2_LOOP:
  s_waitcnt vmcnt(6) lgkmcnt(0)
  ds_write_b128 v57, v[64:67]
  ds_write_b128 v57, v[68:71] offset:1152
  v_and_b32 v48, 0xff, v58
  v_and_b32 v49, 0xff, v59
  v_and_b32 v50, 0xff, v60
  v_and_b32 v51, 0xff, v61
  s_waitcnt lgkmcnt(0)
  ds_read_b128 v[38:41], v5
  ds_read_b128 v[42:45], v5 offset:64
  ds_read_b64_tr_b16 v[116:117], v6 offset:0
  ds_read_b64_tr_b16 v[118:119], v6 offset:32
  ds_read_b64_tr_b16 v[120:121], v6 offset:64
  ds_read_b64_tr_b16 v[122:123], v6 offset:96
  v_lshrrev_b32 v35, 8, v36
  v_lshl_add_u32 v35, v35, 7, v56
  buffer_load_dwordx4 v[64:67], v35, s[16:19], 0 offen
  v_lshrrev_b32 v35, 8, v37
  v_lshl_add_u32 v35, v35, 7, v56
  buffer_load_dwordx4 v[68:71], v35, s[16:19], 0 offen
  ds_read_b32 v36, v33 offset:4416
  ds_read_b32 v37, v33 offset:4448
  ds_read_b128 v[58:61], v34 offset:4160
  s_waitcnt lgkmcnt(7)
  v_mfma_f32_16x16x32_bf16 v[112:115], v[38:41], v[16:19], 0
  v_mfma_f32_16x16x32_bf16 v[112:115], v[42:45], v[20:23], v[112:115]
  v_cmp_eq_u32 s[72:73], v48, v3
  v_cmp_eq_u32 s[74:75], v49, v3
  v_cmp_eq_u32 s[76:77], v50, v3
  v_cmp_eq_u32 s[78:79], v51, v3
  s_nop 4
  v_mul_f32 v112, s70, v112
  v_mul_f32 v113, s70, v113
  v_mul_f32 v114, s70, v114
  v_mul_f32 v115, s70, v115
  v_exp_f32 v112, v112
  v_exp_f32 v113, v113
  v_exp_f32 v114, v114
  v_exp_f32 v115, v115
  v_add_f32 v112, 1.0, v112
  v_add_f32 v113, 1.0, v113
  v_add_f32 v114, 1.0, v114
  v_add_f32 v115, 1.0, v115
  v_rcp_f32 v112, v112
  v_rcp_f32 v113, v113
  v_rcp_f32 v114, v114
  v_rcp_f32 v115, v115
  s_nop 0
  v_cndmask_b32 v112, 0, v112, s[72:73]
  v_cndmask_b32 v113, 0, v113, s[74:75]
  v_cndmask_b32 v114, 0, v114, s[76:77]
  v_cndmask_b32 v115, 0, v115, s[78:79]
  v_cvt_pk_bf16_f32 v124, v112, v113
  v_cvt_pk_bf16_f32 v125, v114, v115
  s_waitcnt lgkmcnt(3)
  s_nop 0
  v_mfma_f32_16x16x16_bf16 v[96:99], v[116:117], v[124:125], v[96:99]
  v_mfma_f32_16x16x16_bf16 v[100:103], v[118:119], v[124:125], v[100:103]
  v_mfma_f32_16x16x16_bf16 v[104:107], v[120:121], v[124:125], v[104:107]
  v_mfma_f32_16x16x16_bf16 v[108:111], v[122:123], v[124:125], v[108:111]
  s_add_u32 s64, s64, 1
  s_cmp_ge_u32 s64, s65
  s_cbranch_scc1 K2_LOOPEND
  s_waitcnt vmcnt(6) lgkmcnt(0)
  ds_write_b128 v57, v[72:75]
  ds_write_b128 v57, v[76:79] offset:1152
  v_and_b32 v48, 0xff, v58
  v_and_b32 v49, 0xff, v59
  v_and_b32 v50, 0xff, v60
  v_and_b32 v51, 0xff, v61
  s_waitcnt lgkmcnt(0)
  ds_read_b128 v[38:41], v5
  ds_read_b128 v[42:45], v5 offset:64
  ds_read_b64_tr_b16 v[116:117], v6 offset:0
  ds_read_b64_tr_b16 v[118:119], v6 offset:32
  ds_read_b64_tr_b16 v[120:121], v6 offset:64
  ds_read_b64_tr_b16 v[122:123], v6 offset:96
  v_lshrrev_b32 v35, 8, v36
  v_lshl_add_u32 v35, v35, 7, v56
  buffer_load_dwordx4 v[72:75], v35, s[16:19], 0 offen
  v_lshrrev_b32 v35, 8, v37
  v_lshl_add_u32 v35, v35, 7, v56
  buffer_load_dwordx4 v[76:79], v35, s[16:19], 0 offen
  ds_read_b32 v36, v33 offset:4480
  ds_read_b32 v37, v33 offset:4512
  ds_read_b128 v[58:61], v34 offset:4224
  s_waitcnt lgkmcnt(7)
  v_mfma_f32_16x16x32_bf16 v[112:115], v[38:41], v[16:19], 0
  v_mfma_f32_16x16x32_bf16 v[112:115], v[42:45], v[20:23], v[112:115]
  v_cmp_eq_u32 s[72:73], v48, v3
  v_cmp_eq_u32 s[74:75], v49, v3
  v_cmp_eq_u32 s[76:77], v50, v3
  v_cmp_eq_u32 s[78:79], v51, v3
  s_nop 4
  v_mul_f32 v112, s70, v112
  v_mul_f32 v113, s70, v113
  v_mul_f32 v114, s70, v114
  v_mul_f32 v115, s70, v115
  v_exp_f32 v112, v112
  v_exp_f32 v113, v113
  v_exp_f32 v114, v114
  v_exp_f32 v115, v115
  v_add_f32 v112, 1.0, v112
  v_add_f32 v113, 1.0, v113
  v_add_f32 v114, 1.0, v114
  v_add_f32 v115, 1.0, v115
  v_rcp_f32 v112, v112
  v_rcp_f32 v113, v113
  v_rcp_f32 v114, v114
  v_rcp_f32 v115, v115
  s_nop 0
  v_cndmask_b32 v112, 0, v112, s[72:73]
  v_cndmask_b32 v113, 0, v113, s[74:75]
  v_cndmask_b32 v114, 0, v114, s[76:77]
  v_cndmask_b32 v115, 0, v115, s[78:79]
  v_cvt_pk_bf16_f32 v124, v112, v113
  v_cvt_pk_bf16_f32 v125, v114, v115
  s_waitcnt lgkmcnt(3)
  s_nop 0
  v_mfma_f32_16x16x16_bf16 v[96:99], v[116:117], v[124:125], v[96:99]
  v_mfma_f32_16x16x16_bf16 v[100:103], v[118:119], v[124:125], v[100:103]
  v_mfma_f32_16x16x16_bf16 v[104:107], v[120:121], v[124:125], v[104:107]
  v_mfma_f32_16x16x16_bf16 v[108:111], v[122:123], v[124:125], v[108:111]
  s_add_u32 s64, s64, 1
  s_cmp_ge_u32 s64, s65
  s_cbranch_scc1 K2_LOOPEND
  s_waitcnt vmcnt(6) lgkmcnt(0)
  ds_write_b128 v57, v[80:83]
  ds_write_b128 v57, v[84:87] offset:1152
  v_and_b32 v48, 0xff, v58
  v_and_b32 v49, 0xff, v59
  v_and_b32 v50, 0xff, v60
  v_and_b32 v51, 0xff, v61
  s_waitcnt lgkmcnt(0)
  ds_read_b128 v[38:41], v5
  ds_read_b128 v[42:45], v5 offset:64
  ds_read_b64_tr_b16 v[116:117], v6 offset:0
  ds_read_b64_tr_b16 v[118:119], v6 offset:32
  ds_read_b64_tr_b16 v[120:121], v6 offset:64
  ds_read_b64_tr_b16 v[122:123], v6 offset:96
  v_lshrrev_b32 v35, 8, v36
  v_lshl_add_u32 v35, v35, 7, v56
  buffer_load_dwordx4 v[80:83], v35, s[16:19], 0 offen
  v_lshrrev_b32 v35, 8, v37
  v_lshl_add_u32 v35, v35, 7, v56
  buffer_load_dwordx4 v[84:87], v35, s[16:19], 0 offen
  ds_read_b32 v36, v33 offset:4544
  ds_read_b32 v37, v33 offset:4576
  ds_read_b128 v[58:61], v34 offset:4288
  s_waitcnt lgkmcnt(7)
  v_mfma_f32_16x16x32_bf16 v[112:115], v[38:41], v[16:19], 0
  v_mfma_f32_16x16x32_bf16 v[112:115], v[42:45], v[20:23], v[112:115]
  v_cmp_eq_u32 s[72:73], v48, v3
  v_cmp_eq_u32 s[74:75], v49, v3
  v_cmp_eq_u32 s[76:77], v50, v3
  v_cmp_eq_u32 s[78:79], v51, v3
  s_nop 4
  v_mul_f32 v112, s70, v112
  v_mul_f32 v113, s70, v113
  v_mul_f32 v114, s70, v114
  v_mul_f32 v115, s70, v115
  v_exp_f32 v112, v112
  v_exp_f32 v113, v113
  v_exp_f32 v114, v114
  v_exp_f32 v115, v115
  v_add_f32 v112, 1.0, v112
  v_add_f32 v113, 1.0, v113
  v_add_f32 v114, 1.0, v114
  v_add_f32 v115, 1.0, v115
  v_rcp_f32 v112, v112
  v_rcp_f32 v113, v113
  v_rcp_f32 v114, v114
  v_rcp_f32 v115, v115
  s_nop 0
  v_cndmask_b32 v112, 0, v112, s[72:73]
  v_cndmask_b32 v113, 0, v113, s[74:75]
  v_cndmask_b32 v114, 0, v114, s[76:77]
  v_cndmask_b32 v115, 0, v115, s[78:79]
  v_cvt_pk_bf16_f32 v124, v112, v113
  v_cvt_pk_bf16_f32 v125, v114, v115
  s_waitcnt lgkmcnt(3)
  s_nop 0
  v_mfma_f32_16x16x16_bf16 v[96:99], v[116:117], v[124:125], v[96:99]
  v_mfma_f32_16x16x16_bf16 v[100:103], v[118:119], v[124:125], v[100:103]
  v_mfma_f32_16x16x16_bf16 v[104:107], v[120:121], v[124:125], v[104:107]
  v_mfma_f32_16x16x16_bf16 v[108:111], v[122:123], v[124:125], v[108:111]
  s_add_u32 s64, s64, 1
  s_cmp_ge_u32 s64, s65
  s_cbranch_scc1 K2_LOOPEND
  s_waitcnt vmcnt(6) lgkmcnt(0)
  ds_write_b128 v57, v[88:91]
  ds_write_b128 v57, v[92:95] offset:1152
  v_and_b32 v48, 0xff, v58
  v_and_b32 v49, 0xff, v59
  v_and_b32 v50, 0xff, v60
  v_and_b32 v51, 0xff, v61
  s_waitcnt lgkmcnt(0)
  ds_read_b128 v[38:41], v5
  ds_read_b128 v[42:45], v5 offset:64
  ds_read_b64_tr_b16 v[116:117], v6 offset:0
  ds_read_b64_tr_b16 v[118:119], v6 offset:32
  ds_read_b64_tr_b16 v[120:121], v6 offset:64
  ds_read_b64_tr_b16 v[122:123], v6 offset:96
  v_lshrrev_b32 v35, 8, v36
  v_lshl_add_u32 v35, v35, 7, v56
  buffer_load_dwordx4 v[88:91], v35, s[16:19], 0 offen
  v_lshrrev_b32 v35, 8, v37
  v_lshl_add_u32 v35, v35, 7, v56
  buffer_load_dwordx4 v[92:95], v35, s[16:19], 0 offen
  ds_read_b32 v36, v33 offset:4608
  ds_read_b32 v37, v33 offset:4640
  ds_read_b128 v[58:61], v34 offset:4352
  s_waitcnt lgkmcnt(7)
  v_mfma_f32_16x16x32_bf16 v[112:115], v[38:41], v[16:19], 0
  v_mfma_f32_16x16x32_bf16 v[112:115], v[42:45], v[20:23], v[112:115]
  v_cmp_eq_u32 s[72:73], v48, v3
  v_cmp_eq_u32 s[74:75], v49, v3
  v_cmp_eq_u32 s[76:77], v50, v3
  v_cmp_eq_u32 s[78:79], v51, v3
  s_nop 4
  v_mul_f32 v112, s70, v112
  v_mul_f32 v113, s70, v113
  v_mul_f32 v114, s70, v114
  v_mul_f32 v115, s70, v115
  v_exp_f32 v112, v112
  v_exp_f32 v113, v113
  v_exp_f32 v114, v114
  v_exp_f32 v115, v115
  v_add_f32 v112, 1.0, v112
  v_add_f32 v113, 1.0, v113
  v_add_f32 v114, 1.0, v114
  v_add_f32 v115, 1.0, v115
  v_rcp_f32 v112, v112
  v_rcp_f32 v113, v113
  v_rcp_f32 v114, v114
  v_rcp_f32 v115, v115
  s_nop 0
  v_cndmask_b32 v112, 0, v112, s[72:73]
  v_cndmask_b32 v113, 0, v113, s[74:75]
  v_cndmask_b32 v114, 0, v114, s[76:77]
  v_cndmask_b32 v115, 0, v115, s[78:79]
  v_cvt_pk_bf16_f32 v124, v112, v113
  v_cvt_pk_bf16_f32 v125, v114, v115
  s_waitcnt lgkmcnt(3)
  s_nop 0
  v_mfma_f32_16x16x16_bf16 v[96:99], v[116:117], v[124:125], v[96:99]
  v_mfma_f32_16x16x16_bf16 v[100:103], v[118:119], v[124:125], v[100:103]
  v_mfma_f32_16x16x16_bf16 v[104:107], v[120:121], v[124:125], v[104:107]
  v_mfma_f32_16x16x16_bf16 v[108:111], v[122:123], v[124:125], v[108:111]
  v_add_u32 v33, 256, v33
  v_add_u32 v34, 256, v34
  s_add_u32 s64, s64, 1
  s_cmp_ge_u32 s64, s65
  s_cbranch_scc1 K2_LOOPEND
  s_branch K2_LOOP
K2_LOOPEND:
K2_P2DONE:
  s_waitcnt vmcnt(0) lgkmcnt(0)
  s_barrier
  s_add_u32 s43, s43, 4096
  s_cmp_lt_u32 s43, s42
  s_cbranch_scc1 K2_ROUND
  v_lshlrev_b32 v8, 4, v1
  v_add_u32 v8, 8192, v8
  v_add_u32 v9, 4096, v8
  buffer_load_dwordx4 v[64:67], v8, s[20:23], 0 offen offset:0
  buffer_load_dwordx4 v[68:71], v8, s[20:23], 0 offen offset:1024
  buffer_load_dwordx4 v[72:75], v8, s[20:23], 0 offen offset:2048
  buffer_load_dwordx4 v[76:79], v8, s[20:23], 0 offen offset:3072
  buffer_load_dwordx4 v[80:83], v9, s[20:23], 0 offen offset:0
  buffer_load_dwordx4 v[84:87], v9, s[20:23], 0 offen offset:1024
  buffer_load_dwordx4 v[88:91], v9, s[20:23], 0 offen offset:2048
  buffer_load_dwordx4 v[92:95], v9, s[20:23], 0 offen offset:3072
  s_nop 7
  v_cvt_pk_bf16_f32 v36, v96, v97
  v_cvt_pk_bf16_f32 v37, v98, v99
  v_cvt_pk_bf16_f32 v38, v100, v101
  v_cvt_pk_bf16_f32 v39, v102, v103
  v_cvt_pk_bf16_f32 v40, v104, v105
  v_cvt_pk_bf16_f32 v41, v106, v107
  v_cvt_pk_bf16_f32 v42, v108, v109
  v_cvt_pk_bf16_f32 v43, v110, v111
  s_waitcnt vmcnt(0)
  v_mfma_f32_16x16x16_bf16 v[112:115], v[64:65], v[36:37], 0
  v_mfma_f32_16x16x16_bf16 v[112:115], v[66:67], v[38:39], v[112:115]
  v_mfma_f32_16x16x16_bf16 v[112:115], v[80:81], v[40:41], v[112:115]
  v_mfma_f32_16x16x16_bf16 v[112:115], v[82:83], v[42:43], v[112:115]
  v_mfma_f32_16x16x16_bf16 v[116:119], v[68:69], v[36:37], 0
  v_mfma_f32_16x16x16_bf16 v[116:119], v[70:71], v[38:39], v[116:119]
  v_mfma_f32_16x16x16_bf16 v[116:119], v[84:85], v[40:41], v[116:119]
  v_mfma_f32_16x16x16_bf16 v[116:119], v[86:87], v[42:43], v[116:119]
  v_mfma_f32_16x16x16_bf16 v[120:123], v[72:73], v[36:37], 0
  v_mfma_f32_16x16x16_bf16 v[120:123], v[74:75], v[38:39], v[120:123]
  v_mfma_f32_16x16x16_bf16 v[120:123], v[88:89], v[40:41], v[120:123]
  v_mfma_f32_16x16x16_bf16 v[120:123], v[90:91], v[42:43], v[120:123]
  v_mfma_f32_16x16x16_bf16 v[124:127], v[76:77], v[36:37], 0
  v_mfma_f32_16x16x16_bf16 v[124:127], v[78:79], v[38:39], v[124:127]
  v_mfma_f32_16x16x16_bf16 v[124:127], v[92:93], v[40:41], v[124:127]
  v_mfma_f32_16x16x16_bf16 v[124:127], v[94:95], v[42:43], v[124:127]
  s_nop 7
  s_nop 7
  s_lshl_b32 s3, s44, 4
  v_add_u32 v28, s3, v3
  v_cmp_gt_u32 vcc, s41, v28
  s_and_b64 exec, exec, vcc
  v_add_u32 v28, s40, v28
  v_lshlrev_b32 v28, 7, v28
  v_lshl_add_u32 v28, v4, 3, v28
  v_cvt_pk_bf16_f32 v44, v112, v113
  v_cvt_pk_bf16_f32 v45, v114, v115
  buffer_store_dwordx2 v[44:45], v28, s[28:31], 0 offen offset:0
  v_cvt_pk_bf16_f32 v46, v116, v117
  v_cvt_pk_bf16_f32 v47, v118, v119
  buffer_store_dwordx2 v[46:47], v28, s[28:31], 0 offen offset:32
  v_cvt_pk_bf16_f32 v48, v120, v121
  v_cvt_pk_bf16_f32 v49, v122, v123
  buffer_store_dwordx2 v[48:49], v28, s[28:31], 0 offen offset:64
  v_cvt_pk_bf16_f32 v50, v124, v125
  v_cvt_pk_bf16_f32 v51, v126, v127
  buffer_store_dwordx2 v[50:51], v28, s[28:31], 0 offen offset:96
K2_END:
  s_endpgm
.section .rodata,"a"
.p2align 6
.amdhsa_kernel fg_part_kernel
  .amdhsa_next_free_vgpr 40
  .amdhsa_next_free_sgpr 88
  .amdhsa_accum_offset 40
  .amdhsa_group_segment_fixed_size 0
  .amdhsa_kernarg_size 64
  .amdhsa_user_sgpr_count 2
  .amdhsa_user_sgpr_kernarg_segment_ptr 1
  .amdhsa_system_sgpr_workgroup_id_x 1
.end_amdhsa_kernel
.p2align 6
.amdhsa_kernel standalone__kernel_systems_refs_featgraph__graph_kernel
  .amdhsa_next_free_vgpr 128
  .amdhsa_next_free_sgpr 88
  .amdhsa_accum_offset 128
  .amdhsa_group_segment_fixed_size 0
  .amdhsa_kernarg_size 64
  .amdhsa_user_sgpr_count 2
  .amdhsa_user_sgpr_kernarg_segment_ptr 1
  .amdhsa_system_sgpr_workgroup_id_x 1
.end_amdhsa_kernel
```
